```python
import torch

def _softmax(x, axis=-1):
    return torch.softmax(x, dim=axis)

def _gelu(x):
    return torch.nn.functional.gelu(x, approximate='tanh')

def _silu(x):
    return torch.nn.functional.silu(x)

def _sigmoid(x):
    return torch.sigmoid(x)

def _layernorm(x, axis=-1, eps=1e-05):
    m = x.mean(dim=axis, keepdim=True)
    v = x.var(dim=axis, keepdim=True, unbiased=False)
    return (x - m) / torch.sqrt(v + eps)

def _scatter_add(tgt, idx, src, axis=0):
    return tgt.clone().index_add_(axis, idx, src)

def _segment_sum(src, seg, n):
    out = torch.zeros((n,) + src.shape[1:], dtype=src.dtype)
    return out.index_add_(0, seg, src)

def _pad(x, pw):
    flat = tuple((v for pair in reversed(pw) for v in pair))
    return torch.nn.functional.pad(x, flat)
kernel_name = 'standalone__tree_speculative_verify_tree_attention_over_candidate_token_tree__decode'

def setup_inputs():

    _w = lambda a: (lambda t: t.to(torch.bfloat16) if t.is_floating_point() else t)(torch.as_tensor(a))
    B, Hq, Hkv, T, C, D = (2, 32, 8, 1, 32768, 128)
    tree_mask = torch.zeros((B, T, T), dtype=float)
    for b in range(B):
        parent = torch.zeros(T, dtype=torch.int64)
        for i in range(1, T):
            parent[i] = int(torch.randint(0, i, (1,)).item())
        for i in range(T):
            j = i
            tree_mask[b, i, j] = 1.0
            while j > 0:
                j = parent[j]
                tree_mask[b, i, j] = 1.0
    return {'q': _w((lambda *s: torch.randn(*s, dtype=torch.bfloat16) * 0.8)(B, Hq, T, D)), 'k_cache': _w((lambda *s: torch.randn(*s, dtype=torch.bfloat16) * 0.8)(B, Hkv, C, D)), 'v_cache': _w((lambda *s: torch.randn(*s, dtype=torch.bfloat16) * 0.05)(B, Hkv, C, D)), 'k_tree': _w((lambda *s: torch.randn(*s, dtype=torch.bfloat16) * 0.8)(B, Hkv, T, D)), 'v_tree': _w((lambda *s: torch.randn(*s, dtype=torch.bfloat16) * 0.05)(B, Hkv, T, D)), 'tree_mask': _w(tree_mask)}

def reference(q, k_cache, v_cache, k_tree, v_tree, tree_mask):
    B, Hq, T, D = q.shape
    Hkv, C = (k_cache.shape[1], k_cache.shape[2])
    rep = Hq // Hkv
    kc = (lambda x, n, axis: torch.repeat_interleave(x, n, dim=axis))(k_cache, rep, axis=1)
    vc = (lambda x, n, axis: torch.repeat_interleave(x, n, dim=axis))(v_cache, rep, axis=1)
    kt = (lambda x, n, axis: torch.repeat_interleave(x, n, dim=axis))(k_tree, rep, axis=1)
    vt = (lambda x, n, axis: torch.repeat_interleave(x, n, dim=axis))(v_tree, rep, axis=1)
    k = torch.concatenate([kc, kt], axis=2)
    v = torch.concatenate([vc, vt], axis=2)
    scale = D ** (-0.5)
    scores = torch.einsum('bhqd,bhkd->bhqk', q, k) * scale
    ctx_mask = torch.ones((B, 1, T, C), dtype=scores.dtype)
    tm = tree_mask[:, None, :, :].clone()
    full_mask = torch.concatenate([ctx_mask, tm], axis=-1)
    scores = scores + (1.0 - full_mask) * -1000000000.0
    p = _softmax(scores, axis=-1)
    return torch.einsum('bhqk,bhkd->bhqd', p, v)
```

```asm
; @launch grid=(256,1,1) block=(320,1,1) lds=83968
.amdgcn_target "amdgcn-amd-amdhsa--gfx950"
.text
.globl standalone__tree_speculative_verify_tree_attention_over_candidate_token_tree__decode_kernel
.p2align 8
.type standalone__tree_speculative_verify_tree_attention_over_candidate_token_tree__decode_kernel,@function
standalone__tree_speculative_verify_tree_attention_over_candidate_token_tree__decode_kernel:
    s_load_dwordx2 s[24:25], s[0:1], 8
    s_load_dwordx2 s[32:33], s[0:1], 0
    v_readfirstlane_b32 s48, v0
    v_and_b32 v1, 51, v0
    v_mul_u32_u24 v1, 20, v1
    v_and_b32 v1, 0xf0, v1
    s_cmpk_ge_u32 s48, 0x100
    s_cbranch_scc1 L_helper
    v_and_b32 v108, 8, v0
    v_mul_u32_u24 v108, 0x1020, v108
    v_or_b32 v144, v108, v1
    v_and_b32 v108, 4, v0
    v_lshl_or_b32 v144, v108, 18, v144
    s_cmpk_ge_u32 s2, 0x100
    s_cbranch_scc1 L_end
    s_bitcmp1_b32 s2, 0
    s_cselect_b32 s3, 0x19a00, 0
    s_bitcmp1_b32 s2, 1
    s_cselect_b32 s22, 0xbf00, 0
    s_xor_b32 s3, s3, s22
    s_bitcmp1_b32 s2, 2
    s_cselect_b32 s22, 0x101b00, 0
    s_xor_b32 s3, s3, s22
    s_bitcmp1_b32 s2, 3
    s_cselect_b32 s22, 0x104600, 0
    s_xor_b32 s3, s3, s22
    s_bitcmp1_b32 s2, 4
    s_cselect_b32 s22, 0x919400, 0
    s_xor_b32 s3, s3, s22
    s_bitcmp1_b32 s2, 5
    s_cselect_b32 s22, 0x1401400, 0
    s_xor_b32 s3, s3, s22
    s_bitcmp1_b32 s2, 6
    s_cselect_b32 s22, 0x2400c00, 0
    s_xor_b32 s3, s3, s22
    s_bitcmp1_b32 s2, 7
    s_cselect_b32 s22, 0x4500200, 0
    s_xor_b32 s3, s3, s22
    s_bitcmp1_b32 s48, 6
    s_cselect_b32 s22, 0x42200, 0
    s_xor_b32 s3, s3, s22
    s_bitcmp1_b32 s48, 7
    s_cselect_b32 s22, 0x8500, 0
    s_xor_b32 s3, s3, s22
    v_xor_b32 v144, s3, v144
    s_lshl_b32 s26, 1, 27
    s_lshl_b32 s27, 1, 17
    s_waitcnt lgkmcnt(0)
    buffer_load_dwordx4 v[8:11], v144, s[24:27], 0 offen offset:0 nt
    s_load_dword s94, s[32:33], 0
    v_xor_b32 v145, 0x212000, v144
    buffer_load_dwordx4 v[12:15], v145, s[24:27], 0 offen offset:0 nt
    v_xor_b32 v146, 0x20400, v144
    buffer_load_dwordx4 v[16:19], v146, s[24:27], 0 offen offset:0 nt
    v_xor_b32 v147, 0x20400, v145
    buffer_load_dwordx4 v[20:23], v147, s[24:27], 0 offen offset:0 nt
    v_xor_b32 v148, 0x18c500, v144
    v_xor_b32 v149, 0x18c500, v145
    v_xor_b32 v150, 0x18c500, v146
    v_xor_b32 v151, 0x18c500, v147
    s_lshr_b32 s49, s2, 4
    s_mov_b32 s62, s2
    s_lshl_b32 s22, s49, 10
    s_movk_i32 s34, 0x4000
    s_mov_b32 s35, s27
    v_and_b32 v111, 12, v0
    v_lshl_or_b32 v111, v111, 6, v1
    buffer_load_dwordx4 v[4:7], v111, s[32:35], s22 offen
    buffer_load_dwordx4 v[24:27], v148, s[24:27], 0 offen offset:0 nt
    buffer_load_dwordx4 v[28:31], v149, s[24:27], 0 offen offset:0 nt
    s_mov_b32 s61, 0x110200
    s_mov_b32 s50, 0x510300
    s_mov_b32 s60, 2
    s_load_dwordx2 s[8:9], s[0:1], 16
    s_load_dwordx4 s[16:19], s[0:1], 48
    s_load_dwordx2 s[36:37], s[0:1], 64
    s_lshr_b32 s48, s48, 6
    v_and_b32 v0, 63, v0
    s_mov_b32 s86, 0xff800000
    s_mov_b32 s87, s86
    s_mov_b32 s84, 0x11111111
    s_mov_b32 s85, s84
    v_mov_b32 v3, 0x3e0293ee
    v_mov_b64 v[56:57], s[86:87]
    v_mov_b64 v[58:59], s[86:87]
    v_mov_b64 v[60:61], s[86:87]
    v_mov_b64 v[62:63], s[86:87]
    v_mov_b64 v[64:65], s[86:87]
    v_mov_b64 v[66:67], s[86:87]
    v_mov_b64 v[68:69], s[86:87]
    v_mov_b64 v[70:71], s[86:87]
    v_mov_b32 v106, s86
    s_mul_i32 s22, s48, 8448
    v_and_b32 v2, 60, v0
    v_lshl_add_u32 v2, v2, 2, s22
    s_mov_b32 s51, 16
    s_waitcnt vmcnt(5)
    buffer_load_dwordx4 v[32:35], v150, s[24:27], 0 offen offset:0 nt
    s_waitcnt vmcnt(5)
    buffer_load_dwordx4 v[36:39], v151, s[24:27], 0 offen offset:0 nt
    v_xor_b32 v144, s61, v144
    v_xor_b32 v145, s61, v145
    v_xor_b32 v146, s61, v146
    v_xor_b32 v147, s61, v147
    v_xor_b32 v148, s61, v148
    v_xor_b32 v149, s61, v149
    v_xor_b32 v150, s61, v150
    v_xor_b32 v151, s61, v151
    s_waitcnt vmcnt(4)
L_kloop:
    v_mfma_f32_16x16x32_bf16 v[40:43], v[8:11], v[4:7], 0
    s_waitcnt vmcnt(4)
    buffer_load_dwordx4 v[8:11], v144, s[24:27], 0 offen offset:0 nt
    v_xor_b32 v144, s50, v144
    v_mul_f32_dpp v72, v56, v3 quad_perm:[0,0,0,0] row_mask:0xf bank_mask:0xf
    v_mul_f32_dpp v73, v60, v3 quad_perm:[0,0,0,0] row_mask:0xf bank_mask:0xf
    v_mul_f32_dpp v74, v64, v3 quad_perm:[0,0,0,0] row_mask:0xf bank_mask:0xf
    v_mul_f32_dpp v75, v68, v3 quad_perm:[0,0,0,0] row_mask:0xf bank_mask:0xf
    v_mfma_f32_16x16x32_bf16 v[44:47], v[12:15], v[4:7], 0
    s_waitcnt vmcnt(4)
    buffer_load_dwordx4 v[12:15], v145, s[24:27], 0 offen offset:0 nt
    v_xor_b32 v145, s50, v145
    v_fmac_f32_dpp v72, v57, v3 quad_perm:[1,1,1,1] row_mask:0xf bank_mask:0xf
    v_fmac_f32_dpp v73, v61, v3 quad_perm:[1,1,1,1] row_mask:0xf bank_mask:0xf
    v_fmac_f32_dpp v74, v65, v3 quad_perm:[1,1,1,1] row_mask:0xf bank_mask:0xf
    v_fmac_f32_dpp v75, v69, v3 quad_perm:[1,1,1,1] row_mask:0xf bank_mask:0xf
    v_mfma_f32_16x16x32_bf16 v[48:51], v[16:19], v[4:7], 0
    s_waitcnt vmcnt(4)
    buffer_load_dwordx4 v[16:19], v146, s[24:27], 0 offen offset:0 nt
    v_xor_b32 v146, s50, v146
    v_fmac_f32_dpp v72, v58, v3 quad_perm:[2,2,2,2] row_mask:0xf bank_mask:0xf
    v_fmac_f32_dpp v73, v62, v3 quad_perm:[2,2,2,2] row_mask:0xf bank_mask:0xf
    v_fmac_f32_dpp v74, v66, v3 quad_perm:[2,2,2,2] row_mask:0xf bank_mask:0xf
    v_fmac_f32_dpp v75, v70, v3 quad_perm:[2,2,2,2] row_mask:0xf bank_mask:0xf
    v_mfma_f32_16x16x32_bf16 v[52:55], v[20:23], v[4:7], 0
    s_waitcnt vmcnt(4)
    buffer_load_dwordx4 v[20:23], v147, s[24:27], 0 offen offset:0 nt
    v_xor_b32 v147, s50, v147
    v_fmac_f32_dpp v72, v59, v3 quad_perm:[3,3,3,3] row_mask:0xf bank_mask:0xf
    v_fmac_f32_dpp v73, v63, v3 quad_perm:[3,3,3,3] row_mask:0xf bank_mask:0xf
    v_fmac_f32_dpp v74, v67, v3 quad_perm:[3,3,3,3] row_mask:0xf bank_mask:0xf
    v_fmac_f32_dpp v75, v71, v3 quad_perm:[3,3,3,3] row_mask:0xf bank_mask:0xf
    v_max3_f32 v106, v106, v72, v73
    v_max3_f32 v106, v106, v74, v75
    s_mov_b64 exec, s[84:85]
    ds_write_b128 v2, v[72:75] offset:0
    s_mov_b64 exec, -1
    v_mfma_f32_16x16x32_bf16 v[56:59], v[24:27], v[4:7], 0
    s_waitcnt vmcnt(4)
    buffer_load_dwordx4 v[24:27], v148, s[24:27], 0 offen offset:0 nt
    v_xor_b32 v148, s50, v148
    v_mul_f32_dpp v72, v40, v3 quad_perm:[0,0,0,0] row_mask:0xf bank_mask:0xf
    v_mul_f32_dpp v73, v44, v3 quad_perm:[0,0,0,0] row_mask:0xf bank_mask:0xf
    v_mul_f32_dpp v74, v48, v3 quad_perm:[0,0,0,0] row_mask:0xf bank_mask:0xf
    v_mul_f32_dpp v75, v52, v3 quad_perm:[0,0,0,0] row_mask:0xf bank_mask:0xf
    v_mfma_f32_16x16x32_bf16 v[60:63], v[28:31], v[4:7], 0
    s_waitcnt vmcnt(4)
    buffer_load_dwordx4 v[28:31], v149, s[24:27], 0 offen offset:0 nt
    v_xor_b32 v149, s50, v149
    v_fmac_f32_dpp v72, v41, v3 quad_perm:[1,1,1,1] row_mask:0xf bank_mask:0xf
    v_fmac_f32_dpp v73, v45, v3 quad_perm:[1,1,1,1] row_mask:0xf bank_mask:0xf
    v_fmac_f32_dpp v74, v49, v3 quad_perm:[1,1,1,1] row_mask:0xf bank_mask:0xf
    v_fmac_f32_dpp v75, v53, v3 quad_perm:[1,1,1,1] row_mask:0xf bank_mask:0xf
    v_mfma_f32_16x16x32_bf16 v[64:67], v[32:35], v[4:7], 0
    s_waitcnt vmcnt(4)
    buffer_load_dwordx4 v[32:35], v150, s[24:27], 0 offen offset:0 nt
    v_xor_b32 v150, s50, v150
    v_fmac_f32_dpp v72, v42, v3 quad_perm:[2,2,2,2] row_mask:0xf bank_mask:0xf
    v_fmac_f32_dpp v73, v46, v3 quad_perm:[2,2,2,2] row_mask:0xf bank_mask:0xf
    v_fmac_f32_dpp v74, v50, v3 quad_perm:[2,2,2,2] row_mask:0xf bank_mask:0xf
    v_fmac_f32_dpp v75, v54, v3 quad_perm:[2,2,2,2] row_mask:0xf bank_mask:0xf
    v_mfma_f32_16x16x32_bf16 v[68:71], v[36:39], v[4:7], 0
    s_waitcnt vmcnt(4)
    buffer_load_dwordx4 v[36:39], v151, s[24:27], 0 offen offset:0 nt
    v_xor_b32 v151, s50, v151
    s_add_u32 s60, s60, 1
    s_bitcmp1_b32 s60, 0
    s_cselect_b32 s50, s61, 0x510300
    s_and_b32 s22, s60, 3
    s_cselect_b32 s50, s50, 0x419300
    s_and_b32 s22, s60, 7
    s_cselect_b32 s50, s50, 0x559b00
    v_fmac_f32_dpp v72, v43, v3 quad_perm:[3,3,3,3] row_mask:0xf bank_mask:0xf
    v_fmac_f32_dpp v73, v47, v3 quad_perm:[3,3,3,3] row_mask:0xf bank_mask:0xf
    v_fmac_f32_dpp v74, v51, v3 quad_perm:[3,3,3,3] row_mask:0xf bank_mask:0xf
    v_fmac_f32_dpp v75, v55, v3 quad_perm:[3,3,3,3] row_mask:0xf bank_mask:0xf
    v_max3_f32 v106, v106, v72, v73
    v_max3_f32 v106, v106, v74, v75
    s_mov_b64 exec, s[84:85]
    ds_write_b128 v2, v[72:75] offset:256
    s_mov_b64 exec, -1
    v_add_u32 v2, 0x200, v2
    s_sub_u32 s51, s51, 1
    s_cmp_gt_u32 s51, 1
    s_cbranch_scc1 L_kloop
    s_cmp_eq_u32 s51, 0
    s_cbranch_scc1 L_kdone
    s_waitcnt lgkmcnt(0)
    s_mov_b64 s[24:25], s[8:9]
    v_lshrrev_b32 v110, 2, v0
    v_xor_b32 v110, v110, v0
    v_and_b32 v110, 12, v110
    v_lshlrev_b32 v111, 4, v110
    v_and_b32 v108, 8, v110
    v_mul_u32_u24 v108, 0x1020, v108
    v_or_b32 v111, v108, v111
    v_and_b32 v108, 4, v110
    v_lshl_or_b32 v111, v108, 18, v111
    v_xor_b32 v144, v111, v144
    v_xor_b32 v145, v111, v145
    v_xor_b32 v146, v111, v146
    v_xor_b32 v147, v111, v147
    v_xor_b32 v148, v111, v148
    v_xor_b32 v149, v111, v149
    v_xor_b32 v150, v111, v150
    v_xor_b32 v151, v111, v151
    s_branch L_kloop
L_kdone:
    v_mul_f32_dpp v72, v56, v3 quad_perm:[0,0,0,0] row_mask:0xf bank_mask:0xf
    v_mul_f32_dpp v73, v60, v3 quad_perm:[0,0,0,0] row_mask:0xf bank_mask:0xf
    v_mul_f32_dpp v74, v64, v3 quad_perm:[0,0,0,0] row_mask:0xf bank_mask:0xf
    v_mul_f32_dpp v75, v68, v3 quad_perm:[0,0,0,0] row_mask:0xf bank_mask:0xf
    v_fmac_f32_dpp v72, v57, v3 quad_perm:[1,1,1,1] row_mask:0xf bank_mask:0xf
    v_fmac_f32_dpp v73, v61, v3 quad_perm:[1,1,1,1] row_mask:0xf bank_mask:0xf
    v_fmac_f32_dpp v74, v65, v3 quad_perm:[1,1,1,1] row_mask:0xf bank_mask:0xf
    v_fmac_f32_dpp v75, v69, v3 quad_perm:[1,1,1,1] row_mask:0xf bank_mask:0xf
    v_fmac_f32_dpp v72, v58, v3 quad_perm:[2,2,2,2] row_mask:0xf bank_mask:0xf
    v_fmac_f32_dpp v73, v62, v3 quad_perm:[2,2,2,2] row_mask:0xf bank_mask:0xf
    v_fmac_f32_dpp v74, v66, v3 quad_perm:[2,2,2,2] row_mask:0xf bank_mask:0xf
    v_fmac_f32_dpp v75, v70, v3 quad_perm:[2,2,2,2] row_mask:0xf bank_mask:0xf
    v_fmac_f32_dpp v72, v59, v3 quad_perm:[3,3,3,3] row_mask:0xf bank_mask:0xf
    v_fmac_f32_dpp v73, v63, v3 quad_perm:[3,3,3,3] row_mask:0xf bank_mask:0xf
    v_fmac_f32_dpp v74, v67, v3 quad_perm:[3,3,3,3] row_mask:0xf bank_mask:0xf
    v_fmac_f32_dpp v75, v71, v3 quad_perm:[3,3,3,3] row_mask:0xf bank_mask:0xf
    v_max3_f32 v106, v106, v72, v73
    v_max3_f32 v106, v106, v74, v75
    s_mov_b64 exec, s[84:85]
    ds_write_b128 v2, v[72:75] offset:0
    s_mov_b64 exec, -1
    v_mov_b32 v109, v106
    v_subrev_u32 v2, 7936, v2
    v_and_b32 v110, 12, v0
    v_permlane32_swap_b32 v106, v109
    v_max_f32 v106, v106, v109
    v_mov_b32 v109, v106
    v_lshlrev_b32 v110, 2, v110
    s_lshl_b32 s22, s48, 2
    v_permlane16_swap_b32 v106, v109
    v_add_u32 v124, s22, v110
    v_max_f32 v106, v106, v109
    s_mov_b64 exec, 0x1111
    ds_write_b32 v124, v106 offset:41984
    s_mov_b64 exec, -1
    ds_read_b128 v[72:75], v2
    ds_read_b128 v[76:79], v2 offset:256
    v_and_b32 v111, 3, v0
    v_lshlrev_b32 v111, 4, v111
    v_mov_b32 v104, 0xffff
    v_mov_b32 v105, 0
    v_lshlrev_b64 v[104:105], v111, v[104:105]
    v_mov_b64 v[96:97], 0
    v_mov_b64 v[98:99], 0
    v_mov_b64 v[100:101], 0
    v_mov_b64 v[102:103], 0
    v_mov_b32 v107, 0
    s_mov_b32 s51, 15
    s_mov_b32 s56, 1
    s_lshl_b32 s58, s49, 4
    s_waitcnt lgkmcnt(0)
    s_barrier
    ds_read_b128 v[112:115], v110 offset:41984
    s_mov_b64 vcc, -1
    s_waitcnt lgkmcnt(0)
    v_max3_f32 v106, v112, v113, v114
    v_max_f32 v106, v106, v115
    v_sub_f32 v112, v72, v106
    v_sub_f32 v113, v73, v106
    v_sub_f32 v114, v74, v106
    v_sub_f32 v115, v75, v106
    v_exp_f32 v112, v112
    v_exp_f32 v113, v113
    v_exp_f32 v114, v114
    v_exp_f32 v115, v115
    v_cvt_pk_bf16_f32 v116, v112, v112
    v_add_f32 v107, v107, v112
    v_cvt_pk_bf16_f32 v117, v113, v113
    v_add_f32 v107, v107, v113
    v_cvt_pk_bf16_f32 v118, v114, v114
    v_add_f32 v107, v107, v114
    v_cvt_pk_bf16_f32 v119, v115, v115
    v_add_f32 v107, v107, v115
    v_and_b32 v80, v116, v104
    v_and_b32 v81, v116, v105
    v_and_b32 v82, v117, v104
    v_and_b32 v83, v117, v105
    v_and_b32 v84, v118, v104
    v_and_b32 v85, v118, v105
    v_and_b32 v86, v119, v104
    v_and_b32 v87, v119, v105
L_vloop:
    s_waitcnt vmcnt(7)
    v_mfma_f32_16x16x16_bf16 v[96:99], v[80:81], v[8:9], v[96:99]
    v_mfma_f32_16x16x16_bf16 v[100:103], v[80:81], v[10:11], v[100:103]
    s_cbranch_vccz L_p9
    s_waitcnt vmcnt(4)
L_p9:
    buffer_load_dwordx4 v[8:11], v144, s[24:27], 0 offen offset:0 nt
    v_xor_b32 v144, s50, v144
    s_waitcnt lgkmcnt(0)
    ds_read_b128 v[72:75], v2 offset:512
    v_sub_f32 v108, v76, v106
    v_exp_f32 v108, v108
    s_nop 0
    v_cvt_pk_bf16_f32 v109, v108, v108
    v_add_f32 v107, v107, v108
    v_and_b32 v80, v109, v104
    v_and_b32 v81, v109, v105
    s_waitcnt vmcnt(7)
    v_mfma_f32_16x16x16_bf16 v[96:99], v[82:83], v[12:13], v[96:99]
    v_mfma_f32_16x16x16_bf16 v[100:103], v[82:83], v[14:15], v[100:103]
    s_cbranch_vccz L_p10
    s_waitcnt vmcnt(4)
L_p10:
    buffer_load_dwordx4 v[12:15], v145, s[24:27], 0 offen offset:0 nt
    v_xor_b32 v145, s50, v145
    v_sub_f32 v108, v77, v106
    v_exp_f32 v108, v108
    s_nop 0
    v_cvt_pk_bf16_f32 v109, v108, v108
    v_add_f32 v107, v107, v108
    v_and_b32 v82, v109, v104
    v_and_b32 v83, v109, v105
    s_waitcnt vmcnt(7)
    v_mfma_f32_16x16x16_bf16 v[96:99], v[84:85], v[16:17], v[96:99]
    v_mfma_f32_16x16x16_bf16 v[100:103], v[84:85], v[18:19], v[100:103]
    s_cbranch_vccz L_p11
    s_waitcnt vmcnt(4)
L_p11:
    buffer_load_dwordx4 v[16:19], v146, s[24:27], 0 offen offset:0 nt
    v_xor_b32 v146, s50, v146
    v_sub_f32 v108, v78, v106
    v_exp_f32 v108, v108
    s_nop 0
    v_cvt_pk_bf16_f32 v109, v108, v108
    v_add_f32 v107, v107, v108
    v_and_b32 v84, v109, v104
    v_and_b32 v85, v109, v105
    s_waitcnt vmcnt(7)
    v_mfma_f32_16x16x16_bf16 v[96:99], v[86:87], v[20:21], v[96:99]
    v_mfma_f32_16x16x16_bf16 v[100:103], v[86:87], v[22:23], v[100:103]
    s_cbranch_vccz L_p12
    s_waitcnt vmcnt(4)
L_p12:
    buffer_load_dwordx4 v[20:23], v147, s[24:27], 0 offen offset:0 nt
    v_xor_b32 v147, s50, v147
    v_sub_f32 v108, v79, v106
    v_exp_f32 v108, v108
    s_nop 0
    v_cvt_pk_bf16_f32 v109, v108, v108
    v_add_f32 v107, v107, v108
    v_and_b32 v86, v109, v104
    v_and_b32 v87, v109, v105
    s_waitcnt vmcnt(7)
    v_mfma_f32_16x16x16_bf16 v[96:99], v[80:81], v[24:25], v[96:99]
    v_mfma_f32_16x16x16_bf16 v[100:103], v[80:81], v[26:27], v[100:103]
    s_cbranch_vccz L_p13
    s_waitcnt vmcnt(4)
L_p13:
    buffer_load_dwordx4 v[24:27], v148, s[24:27], 0 offen offset:0 nt
    v_xor_b32 v148, s50, v148
    s_waitcnt lgkmcnt(0)
    ds_read_b128 v[76:79], v2 offset:768
    v_sub_f32 v108, v72, v106
    v_exp_f32 v108, v108
    s_nop 0
    v_cvt_pk_bf16_f32 v109, v108, v108
    v_add_f32 v107, v107, v108
    v_and_b32 v80, v109, v104
    v_and_b32 v81, v109, v105
    s_waitcnt vmcnt(7)
    v_mfma_f32_16x16x16_bf16 v[96:99], v[82:83], v[28:29], v[96:99]
    v_mfma_f32_16x16x16_bf16 v[100:103], v[82:83], v[30:31], v[100:103]
    s_cbranch_vccz L_p14
    s_waitcnt vmcnt(4)
L_p14:
    buffer_load_dwordx4 v[28:31], v149, s[24:27], 0 offen offset:0 nt
    v_xor_b32 v149, s50, v149
    v_sub_f32 v108, v73, v106
    v_exp_f32 v108, v108
    s_nop 0
    v_cvt_pk_bf16_f32 v109, v108, v108
    v_add_f32 v107, v107, v108
    v_and_b32 v82, v109, v104
    v_and_b32 v83, v109, v105
    s_waitcnt vmcnt(7)
    v_mfma_f32_16x16x16_bf16 v[96:99], v[84:85], v[32:33], v[96:99]
    v_mfma_f32_16x16x16_bf16 v[100:103], v[84:85], v[34:35], v[100:103]
    s_cbranch_vccz L_p15
    s_waitcnt vmcnt(4)
L_p15:
    buffer_load_dwordx4 v[32:35], v150, s[24:27], 0 offen offset:0 nt
    v_xor_b32 v150, s50, v150
    v_sub_f32 v108, v74, v106
    v_exp_f32 v108, v108
    s_nop 0
    v_cvt_pk_bf16_f32 v109, v108, v108
    v_add_f32 v107, v107, v108
    v_and_b32 v84, v109, v104
    v_and_b32 v85, v109, v105
    s_waitcnt vmcnt(7)
    v_mfma_f32_16x16x16_bf16 v[96:99], v[86:87], v[36:37], v[96:99]
    v_mfma_f32_16x16x16_bf16 v[100:103], v[86:87], v[38:39], v[100:103]
    s_cbranch_vccz L_p16
    s_waitcnt vmcnt(4)
L_p16:
    buffer_load_dwordx4 v[36:39], v151, s[24:27], 0 offen offset:0 nt
    v_xor_b32 v151, s50, v151
    s_add_u32 s60, s60, 1
    s_bitcmp1_b32 s60, 0
    s_cselect_b32 s50, s61, 0x510300
    s_and_b32 s22, s60, 3
    s_cselect_b32 s50, s50, 0x419300
    s_and_b32 s22, s60, 7
    s_cselect_b32 s50, s50, 0x559b00
    v_sub_f32 v108, v75, v106
    v_exp_f32 v108, v108
    s_nop 0
    v_cvt_pk_bf16_f32 v109, v108, v108
    v_add_f32 v107, v107, v108
    v_and_b32 v86, v109, v104
    v_and_b32 v87, v109, v105
    v_add_u32 v2, 0x200, v2
    s_sub_u32 s51, s51, 1
    s_cmp_gt_u32 s51, 3
    s_cselect_b64 vcc, -1, 0
    s_cmp_lg_u32 s51, 0
    s_cbranch_scc1 L_vloop
    s_waitcnt lgkmcnt(0)
    s_cmp_lg_u32 s48, 0
    s_cbranch_scc1 L_notk
    s_atomic_add s56, s[18:19], s58 glc
L_notk:
    s_lshl_b32 s3, s48, 2
    v_readlane_b32 s52, v106, s3
    v_lshlrev_b32 v128, 4, v0
    s_lshl_b32 s22, s48, 11
    v_add_u32 v125, s22, v128
    v_and_b32 v116, 1, v0
    v_bfe_u32 v115, v0, 1, 4
    v_lshlrev_b32 v115, 4, v115
    v_lshl_add_u32 v115, v116, 10, v115
    s_lshl_b32 s22, s48, 8
    v_add_u32 v126, s22, v115
    s_lshl_b32 s3, s49, 10
    s_add_u32 s55, s22, s3
    s_lshl_b32 s22, s48, 4
    v_mov_b32 v127, s22
    s_mov_b32 s38, 0xa2400
    s_mov_b32 s39, 0x20000
    s_lshl_b32 s22, s62, 2
    s_add_u32 s22, s22, s48
    s_lshl_b32 s53, s22, 9
    s_lshl_b32 s54, s22, 7
    s_add_u32 s54, s54, 0x80000
    v_sub_f32 v112, v76, v106
    v_sub_f32 v113, v77, v106
    v_sub_f32 v114, v78, v106
    v_sub_f32 v115, v79, v106
    v_exp_f32 v112, v112
    v_exp_f32 v113, v113
    v_exp_f32 v114, v114
    v_exp_f32 v115, v115
    v_cvt_pk_bf16_f32 v116, v112, v112
    v_add_f32 v107, v107, v112
    v_cvt_pk_bf16_f32 v117, v113, v113
    v_add_f32 v107, v107, v113
    v_cvt_pk_bf16_f32 v118, v114, v114
    v_add_f32 v107, v107, v114
    v_cvt_pk_bf16_f32 v119, v115, v115
    v_add_f32 v107, v107, v115
    v_and_b32 v88, v116, v104
    v_and_b32 v89, v116, v105
    v_and_b32 v90, v117, v104
    v_and_b32 v91, v117, v105
    v_and_b32 v92, v118, v104
    v_and_b32 v93, v118, v105
    v_and_b32 v94, v119, v104
    v_and_b32 v95, v119, v105
    v_mov_b32 v109, v107
    s_nop 1
    v_permlane32_swap_b32 v107, v109
    v_add_f32 v107, v107, v109
    v_mov_b32 v109, v107
    v_mov_b32 v121, 0
    s_nop 0
    v_permlane16_swap_b32 v107, v109
    v_add_f32 v107, v107, v109
    s_mov_b64 exec, 0x1111
    ds_write_b32 v124, v107 offset:42048
    s_mov_b64 exec, -1
    v_lshrrev_b32 v117, 5, v0
    s_movk_i32 s3, 0x600
    v_mad_u32_u24 v118, v117, s3, v128
    v_xor_b32 v132, s53, v118
    v_xor_b32 v133, 0x1000, v132
    v_xor_b32 v134, 0x2000, v132
    v_xor_b32 v135, 0x3000, v132
    v_xor_b32 v136, 0x4000, v132
    v_xor_b32 v137, 0x5000, v132
    v_xor_b32 v138, 0x6000, v132
    v_xor_b32 v139, 0x7000, v132
    v_and_b32 v118, 7, v0
    v_lshl_add_u32 v118, v118, 1, v117
    v_lshlrev_b32 v118, 9, v118
    v_xor_b32 v130, s54, v118
    v_and_b32 v116, 31, v0
    v_lshlrev_b32 v116, 3, v116
    v_lshl_add_u32 v129, v117, 2, v116
    v_lshlrev_b32 v119, 1, v129
    s_lshl_b32 s20, s49, 9
    s_add_u32 s20, s20, 0xa0000
    s_lshr_b32 s21, s55, 4
    s_add_u32 s21, s21, 0xa2000
    s_waitcnt vmcnt(7)
    v_mfma_f32_16x16x16_bf16 v[96:99], v[80:81], v[8:9], v[96:99]
    v_mfma_f32_16x16x16_bf16 v[100:103], v[80:81], v[10:11], v[100:103]
    s_waitcnt vmcnt(6)
    v_mfma_f32_16x16x16_bf16 v[96:99], v[82:83], v[12:13], v[96:99]
    v_mfma_f32_16x16x16_bf16 v[100:103], v[82:83], v[14:15], v[100:103]
    s_waitcnt vmcnt(5)
    v_mfma_f32_16x16x16_bf16 v[96:99], v[84:85], v[16:17], v[96:99]
    v_mfma_f32_16x16x16_bf16 v[100:103], v[84:85], v[18:19], v[100:103]
    s_waitcnt vmcnt(4)
    v_mfma_f32_16x16x16_bf16 v[96:99], v[86:87], v[20:21], v[96:99]
    v_mfma_f32_16x16x16_bf16 v[100:103], v[86:87], v[22:23], v[100:103]
    s_waitcnt lgkmcnt(0)
    v_mov_b32 v120, s56
    s_mov_b64 exec, 1
    ds_write_b32 v124, v120 offset:42112
    s_mov_b64 exec, -1
    s_waitcnt lgkmcnt(0)
    s_barrier
    ds_read_b32 v120, v121 offset:42112
    ds_read_b128 v[112:115], v127 offset:42048
    s_waitcnt lgkmcnt(0)
    v_readfirstlane_b32 s56, v120
    v_pk_add_f32 v[112:113], v[112:113], v[114:115]
    v_add_f32 v112, v112, v113
    s_andn2_b32 s22, 15, s56
    s_cbranch_scc0 L_combine
    s_sub_u32 s22, s54, 512
    v_mov_b32 v116, s53
    s_mov_b32 exec_lo, 0
    v_mov_b32 v116, s22
    s_mov_b32 exec_lo, -1
    v_add_u32 v128, v128, v116
    s_waitcnt vmcnt(3)
    v_mfma_f32_16x16x16_bf16 v[96:99], v[88:89], v[24:25], v[96:99]
    v_mfma_f32_16x16x16_bf16 v[100:103], v[88:89], v[26:27], v[100:103]
    s_waitcnt vmcnt(2)
    v_mfma_f32_16x16x16_bf16 v[96:99], v[90:91], v[28:29], v[96:99]
    v_mfma_f32_16x16x16_bf16 v[100:103], v[90:91], v[30:31], v[100:103]
    s_waitcnt vmcnt(1)
    v_mfma_f32_16x16x16_bf16 v[96:99], v[92:93], v[32:33], v[96:99]
    v_mfma_f32_16x16x16_bf16 v[100:103], v[92:93], v[34:35], v[100:103]
    s_waitcnt vmcnt(0)
    v_mfma_f32_16x16x16_bf16 v[96:99], v[94:95], v[36:37], v[96:99]
    v_mfma_f32_16x16x16_bf16 v[100:103], v[94:95], v[38:39], v[100:103]
    s_nop 7
    ds_write_b128 v125, v[96:99] offset:33792
    ds_write_b128 v125, v[100:103] offset:34816
    s_waitcnt lgkmcnt(0)
    s_barrier
    ds_read_b128 v[80:83], v126 offset:33792
    ds_read_b128 v[84:87], v126 offset:35840
    ds_read_b128 v[88:91], v126 offset:37888
    ds_read_b128 v[92:95], v126 offset:39936
    s_mov_b32 exec_lo, 0
    v_mov_b32 v96, s52
    v_mov_b32 v97, v112
    s_not_b64 exec, exec
    s_waitcnt lgkmcnt(2)
    v_pk_add_f32 v[96:97], v[80:81], v[84:85]
    v_pk_add_f32 v[98:99], v[82:83], v[86:87]
    s_waitcnt lgkmcnt(0)
    v_pk_add_f32 v[100:101], v[88:89], v[92:93]
    v_pk_add_f32 v[102:103], v[90:91], v[94:95]
    v_pk_add_f32 v[96:97], v[96:97], v[100:101]
    v_pk_add_f32 v[98:99], v[98:99], v[102:103]
    s_mov_b32 exec_hi, 1
    buffer_store_dwordx4 v[96:99], v128, s[36:39], 0 offen sc1
    s_endpgm
L_combine:
    v_mov_b32 v120, s52
    v_mov_b32 v121, v112
    s_mov_b32 s44, s16
    s_mov_b32 s45, s17
    s_mov_b32 s46, 0x4000
    s_mov_b32 s47, 0x20000
    s_mov_b32 s59, 0x7fa5a5a5
    s_mov_b32 s51, 16
    s_mov_b32 s3, 0x40000
    buffer_load_dwordx2 v[140:141], v119, s[36:39], s20 offen sc1
    buffer_load_dword v142, off, s[36:39], s21 sc1
    s_mov_b32 exec_lo, 0xfefefefe
    buffer_load_dwordx2 v[120:121], v130, s[36:39], 0 offen sc1
    s_mov_b32 exec_lo, 0
    buffer_load_dwordx4 v[40:43], v132, s[36:39], 0 offen sc1
    s_mov_b32 exec_lo, -1
    buffer_load_dwordx4 v[44:47], v133, s[36:39], 0 offen sc1
    buffer_load_dwordx4 v[48:51], v134, s[36:39], 0 offen sc1
    buffer_load_dwordx4 v[52:55], v135, s[36:39], 0 offen sc1
    buffer_load_dwordx4 v[56:59], v136, s[36:39], 0 offen sc1
    buffer_load_dwordx4 v[60:63], v137, s[36:39], 0 offen sc1
    buffer_load_dwordx4 v[64:67], v138, s[36:39], 0 offen sc1
    buffer_load_dwordx4 v[68:71], v139, s[36:39], 0 offen sc1
    s_waitcnt vmcnt(14)
    v_mfma_f32_16x16x16_bf16 v[96:99], v[88:89], v[24:25], v[96:99]
    v_mfma_f32_16x16x16_bf16 v[100:103], v[88:89], v[26:27], v[100:103]
    s_waitcnt vmcnt(13)
    v_mfma_f32_16x16x16_bf16 v[96:99], v[90:91], v[28:29], v[96:99]
    v_mfma_f32_16x16x16_bf16 v[100:103], v[90:91], v[30:31], v[100:103]
    s_waitcnt vmcnt(12)
    v_mfma_f32_16x16x16_bf16 v[96:99], v[92:93], v[32:33], v[96:99]
    v_mfma_f32_16x16x16_bf16 v[100:103], v[92:93], v[34:35], v[100:103]
    s_waitcnt vmcnt(11)
    v_mfma_f32_16x16x16_bf16 v[96:99], v[94:95], v[36:37], v[96:99]
    v_mfma_f32_16x16x16_bf16 v[100:103], v[94:95], v[38:39], v[100:103]
    s_nop 7
    ds_write_b128 v125, v[96:99] offset:33792
    ds_write_b128 v125, v[100:103] offset:34816
    s_waitcnt lgkmcnt(0)
    s_barrier
    ds_read_b128 v[80:83], v126 offset:33792
    ds_read_b128 v[84:87], v126 offset:35840
    ds_read_b128 v[88:91], v126 offset:37888
    ds_read_b128 v[92:95], v126 offset:39936
    s_branch L_poll1
L_poll:
    s_mov_b32 exec_lo, 0xfefefefe
    buffer_load_dwordx2 v[120:121], v130, s[36:39], 0 offen sc1
    s_mov_b32 exec_lo, 0
    buffer_load_dwordx4 v[40:43], v132, s[36:39], 0 offen sc1
    s_mov_b32 exec_lo, -1
    buffer_load_dwordx4 v[44:47], v133, s[36:39], 0 offen sc1
    buffer_load_dwordx4 v[48:51], v134, s[36:39], 0 offen sc1
    buffer_load_dwordx4 v[52:55], v135, s[36:39], 0 offen sc1
    buffer_load_dwordx4 v[56:59], v136, s[36:39], 0 offen sc1
    buffer_load_dwordx4 v[60:63], v137, s[36:39], 0 offen sc1
    buffer_load_dwordx4 v[64:67], v138, s[36:39], 0 offen sc1
    buffer_load_dwordx4 v[68:71], v139, s[36:39], 0 offen sc1
    s_sub_u32 s3, s3, 1
    s_cbranch_scc1 L_end
L_poll1:
    s_waitcnt vmcnt(8)
    v_cmp_eq_u32 vcc, s59, v120
    v_max_f32 v108, v142, v120
    s_cbranch_vccnz L_poll
    s_nop 0
    v_max_f32_dpp v108, v108, v108 quad_perm:[1,0,3,2] row_mask:0xf bank_mask:0xf
    s_nop 1
    v_max_f32_dpp v108, v108, v108 quad_perm:[2,3,0,1] row_mask:0xf bank_mask:0xf
    s_nop 1
    v_max_f32_dpp v108, v108, v108 row_half_mirror row_mask:0xf bank_mask:0xf
    v_mov_b32 v109, v108
    s_nop 1
    v_permlane32_swap_b32 v108, v109
    v_max_f32 v108, v108, v109
    v_sub_f32 v110, v120, v108
    v_sub_f32 v111, v142, v108
    v_exp_f32 v110, v110
    v_exp_f32 v111, v111
    s_mov_b32 exec_hi, 0
    s_waitcnt lgkmcnt(2)
    v_pk_add_f32 v[96:97], v[80:81], v[84:85]
    v_pk_add_f32 v[98:99], v[82:83], v[86:87]
    s_waitcnt lgkmcnt(0)
    v_pk_add_f32 v[100:101], v[88:89], v[92:93]
    v_pk_add_f32 v[102:103], v[90:91], v[94:95]
    s_waitcnt vmcnt(6)
    v_pk_add_f32 v[40:41], v[96:97], v[100:101]
    v_pk_add_f32 v[42:43], v[98:99], v[102:103]
    s_mov_b32 exec_hi, -1
    v_mul_f32 v108, v110, v121
    v_mov_b32_dpp v122, v110 row_newbcast:0 row_mask:0xf bank_mask:0xf
    v_pk_mul_f32 v[8:9], v[122:123], v[40:41] op_sel_hi:[0,1]
    v_pk_mul_f32 v[10:11], v[122:123], v[42:43] op_sel_hi:[0,1]
    v_add_f32_dpp v108, v108, v108 quad_perm:[1,0,3,2] row_mask:0xf bank_mask:0xf
    v_mov_b32_dpp v122, v110 row_newbcast:1 row_mask:0xf bank_mask:0xf
    v_pk_mul_f32 v[12:13], v[122:123], v[44:45] op_sel_hi:[0,1]
    v_pk_mul_f32 v[14:15], v[122:123], v[46:47] op_sel_hi:[0,1]
    v_pk_add_f32 v[8:9], v[8:9], v[12:13]
    v_pk_add_f32 v[10:11], v[10:11], v[14:15]
    s_waitcnt vmcnt(4)
    v_add_f32_dpp v108, v108, v108 quad_perm:[2,3,0,1] row_mask:0xf bank_mask:0xf
    v_mov_b32_dpp v122, v110 row_newbcast:2 row_mask:0xf bank_mask:0xf
    v_pk_mul_f32 v[16:17], v[122:123], v[48:49] op_sel_hi:[0,1]
    v_pk_mul_f32 v[18:19], v[122:123], v[50:51] op_sel_hi:[0,1]
    v_add_f32_dpp v108, v108, v108 row_half_mirror row_mask:0xf bank_mask:0xf
    v_mov_b32_dpp v122, v110 row_newbcast:3 row_mask:0xf bank_mask:0xf
    v_pk_mul_f32 v[20:21], v[122:123], v[52:53] op_sel_hi:[0,1]
    v_pk_mul_f32 v[22:23], v[122:123], v[54:55] op_sel_hi:[0,1]
    v_pk_add_f32 v[16:17], v[16:17], v[20:21]
    v_pk_add_f32 v[18:19], v[18:19], v[22:23]
    v_pk_add_f32 v[8:9], v[8:9], v[16:17]
    v_pk_add_f32 v[10:11], v[10:11], v[18:19]
    s_waitcnt vmcnt(2)
    v_mov_b32 v109, v108
    v_mov_b32_dpp v122, v110 row_newbcast:4 row_mask:0xf bank_mask:0xf
    v_pk_mul_f32 v[24:25], v[122:123], v[56:57] op_sel_hi:[0,1]
    v_pk_mul_f32 v[26:27], v[122:123], v[58:59] op_sel_hi:[0,1]
    v_permlane32_swap_b32 v108, v109
    v_mov_b32_dpp v122, v110 row_newbcast:5 row_mask:0xf bank_mask:0xf
    v_pk_mul_f32 v[28:29], v[122:123], v[60:61] op_sel_hi:[0,1]
    v_pk_mul_f32 v[30:31], v[122:123], v[62:63] op_sel_hi:[0,1]
    v_pk_add_f32 v[24:25], v[24:25], v[28:29]
    v_pk_add_f32 v[26:27], v[26:27], v[30:31]
    s_waitcnt vmcnt(0)
    v_add_f32 v108, v108, v109
    v_mov_b32_dpp v122, v110 row_newbcast:6 row_mask:0xf bank_mask:0xf
    v_pk_mul_f32 v[32:33], v[122:123], v[64:65] op_sel_hi:[0,1]
    v_pk_mul_f32 v[34:35], v[122:123], v[66:67] op_sel_hi:[0,1]
    v_add_f32 v108, v108, v111
    v_mov_b32_dpp v122, v110 row_newbcast:7 row_mask:0xf bank_mask:0xf
    v_pk_mul_f32 v[36:37], v[122:123], v[68:69] op_sel_hi:[0,1]
    v_pk_mul_f32 v[38:39], v[122:123], v[70:71] op_sel_hi:[0,1]
    v_pk_add_f32 v[32:33], v[32:33], v[36:37]
    v_pk_add_f32 v[34:35], v[34:35], v[38:39]
    v_pk_add_f32 v[24:25], v[24:25], v[32:33]
    v_pk_add_f32 v[26:27], v[26:27], v[34:35]
    v_pk_add_f32 v[8:9], v[8:9], v[24:25]
    v_pk_add_f32 v[10:11], v[10:11], v[26:27]
    v_rcp_f32 v108, v108
    s_nop 0
    v_permlane32_swap_b32 v8, v10
    v_permlane32_swap_b32 v9, v11
    v_add_f32 v8, v8, v10
    v_add_f32 v9, v9, v11
    v_fmac_f32 v8, v111, v140
    v_fmac_f32 v9, v111, v141
    v_mul_f32 v8, v8, v108
    v_mul_f32 v9, v9, v108
    v_cmp_u_f32 vcc, v8, v9
    v_cvt_pk_bf16_f32 v8, v8, v9
    s_cbranch_vccnz L_nan
L_out:
    buffer_store_dword v8, v129, s[44:47], s55 offen
    s_endpgm
L_nan:
    s_sub_u32 s51, s51, 1
    s_cbranch_scc0 L_poll
    s_mov_b32 s51, 0
    v_cmp_eq_u32 s[22:23], s59, v121
    v_cmp_eq_u32 vcc, s59, v40
    s_or_b64 s[22:23], s[22:23], vcc
    v_cmp_eq_u32 vcc, s59, v41
    s_or_b64 s[22:23], s[22:23], vcc
    v_cmp_eq_u32 vcc, s59, v42
    s_or_b64 s[22:23], s[22:23], vcc
    v_cmp_eq_u32 vcc, s59, v43
    s_or_b64 s[22:23], s[22:23], vcc
    v_cmp_eq_u32 vcc, s59, v44
    s_or_b64 s[22:23], s[22:23], vcc
    v_cmp_eq_u32 vcc, s59, v45
    s_or_b64 s[22:23], s[22:23], vcc
    v_cmp_eq_u32 vcc, s59, v46
    s_or_b64 s[22:23], s[22:23], vcc
    v_cmp_eq_u32 vcc, s59, v47
    s_or_b64 s[22:23], s[22:23], vcc
    v_cmp_eq_u32 vcc, s59, v48
    s_or_b64 s[22:23], s[22:23], vcc
    v_cmp_eq_u32 vcc, s59, v49
    s_or_b64 s[22:23], s[22:23], vcc
    v_cmp_eq_u32 vcc, s59, v50
    s_or_b64 s[22:23], s[22:23], vcc
    v_cmp_eq_u32 vcc, s59, v51
    s_or_b64 s[22:23], s[22:23], vcc
    v_cmp_eq_u32 vcc, s59, v52
    s_or_b64 s[22:23], s[22:23], vcc
    v_cmp_eq_u32 vcc, s59, v53
    s_or_b64 s[22:23], s[22:23], vcc
    v_cmp_eq_u32 vcc, s59, v54
    s_or_b64 s[22:23], s[22:23], vcc
    v_cmp_eq_u32 vcc, s59, v55
    s_or_b64 s[22:23], s[22:23], vcc
    v_cmp_eq_u32 vcc, s59, v56
    s_or_b64 s[22:23], s[22:23], vcc
    v_cmp_eq_u32 vcc, s59, v57
    s_or_b64 s[22:23], s[22:23], vcc
    v_cmp_eq_u32 vcc, s59, v58
    s_or_b64 s[22:23], s[22:23], vcc
    v_cmp_eq_u32 vcc, s59, v59
    s_or_b64 s[22:23], s[22:23], vcc
    v_cmp_eq_u32 vcc, s59, v60
    s_or_b64 s[22:23], s[22:23], vcc
    v_cmp_eq_u32 vcc, s59, v61
    s_or_b64 s[22:23], s[22:23], vcc
    v_cmp_eq_u32 vcc, s59, v62
    s_or_b64 s[22:23], s[22:23], vcc
    v_cmp_eq_u32 vcc, s59, v63
    s_or_b64 s[22:23], s[22:23], vcc
    v_cmp_eq_u32 vcc, s59, v64
    s_or_b64 s[22:23], s[22:23], vcc
    v_cmp_eq_u32 vcc, s59, v65
    s_or_b64 s[22:23], s[22:23], vcc
    v_cmp_eq_u32 vcc, s59, v66
    s_or_b64 s[22:23], s[22:23], vcc
    v_cmp_eq_u32 vcc, s59, v67
    s_or_b64 s[22:23], s[22:23], vcc
    v_cmp_eq_u32 vcc, s59, v68
    s_or_b64 s[22:23], s[22:23], vcc
    v_cmp_eq_u32 vcc, s59, v69
    s_or_b64 s[22:23], s[22:23], vcc
    v_cmp_eq_u32 vcc, s59, v70
    s_or_b64 s[22:23], s[22:23], vcc
    v_cmp_eq_u32 vcc, s59, v71
    s_or_b64 s[22:23], s[22:23], vcc
    s_cbranch_scc1 L_poll
    s_branch L_out
L_helper:
    s_cmpk_ge_u32 s2, 0x100
    s_cbranch_scc1 L_end
    s_load_dwordx2 s[36:37], s[0:1], 64
    s_load_dwordx4 s[8:11], s[0:1], 24
    s_load_dwordx2 s[12:13], s[0:1], 40
    v_and_b32 v0, 63, v0
    v_mov_b32 v8, 0x7fa5a5a5
    v_mov_b32 v9, v8
    v_mov_b32 v10, v8
    v_mov_b32 v11, v8
    v_lshlrev_b32 v128, 4, v0
    s_lshr_b32 s49, s2, 4
    s_mov_b32 s62, s2
    s_lshl_b32 s22, s62, 11
    s_lshl_b32 s3, s62, 9
    s_add_u32 s3, s3, 0x80000
    s_mov_b32 s38, 0xa2400
    s_mov_b32 s39, 0x20000
    s_waitcnt lgkmcnt(0)
    buffer_store_dwordx4 v[8:11], v128, s[36:39], s22 offen offset:0 sc1
    buffer_store_dwordx4 v[8:11], v128, s[36:39], s22 offen offset:1024 sc1
    s_mov_b32 exec_hi, 0
    buffer_store_dwordx4 v[8:11], v128, s[36:39], s3 offen sc1
    s_and_b32 s22, s62, 15
    s_cmp_lg_u32 s49, s22
    s_cbranch_scc1 L_hdone
    s_mov_b32 exec_hi, -1
    s_load_dword s88, s[12:13], 0
    s_lshl_b32 s3, s49, 10
    s_movk_i32 s34, 0x4000
    s_mov_b32 s35, 0x20000
    s_lshl_b32 s22, s49, 8
    s_add_u32 s40, s8, s22
    s_addc_u32 s41, s9, 0
    s_movk_i32 s42, 0x100
    s_mov_b32 s43, 0x20000
    s_add_u32 s44, s10, s22
    s_addc_u32 s45, s11, 0
    s_movk_i32 s46, 0x100
    s_mov_b32 s47, 0x20000
    v_and_b32 v111, 12, v0
    v_lshl_or_b32 v111, v111, 6, v1
    v_lshlrev_b32 v113, 3, v0
    buffer_load_dwordx4 v[4:7], v111, s[32:35], s3 offen
    buffer_load_dwordx4 v[72:75], v1, s[40:43], 0 offen
    buffer_load_dwordx2 v[76:77], v113, s[44:47], 0 offen
    v_mov_b32 v3, 0x3e0293ee
    v_lshlrev_b32 v110, 2, v0
    s_lshr_b32 s22, s49, 3
    s_lshl_b32 s22, s22, 4
    s_waitcnt vmcnt(0) lgkmcnt(0)
    v_mfma_f32_16x16x32_bf16 v[40:43], v[72:75], v[4:7], 0
    s_lshr_b32 s88, s88, s22
    s_lshl_b32 s88, s88, 16
    v_sub_f32 v112, 1.0, s88
    v_mul_f32 v112, 0xceabfb8f, v112
    v_lshlrev_b32 v96, 16, v76
    v_and_b32 v97, 0xffff0000, v76
    v_lshlrev_b32 v98, 16, v77
    v_and_b32 v99, 0xffff0000, v77
    s_nop 0
    v_mul_f32_dpp v78, v40, v3 quad_perm:[0,0,0,0] row_mask:0xf bank_mask:0xf
    s_nop 1
    v_fmac_f32_dpp v78, v41, v3 quad_perm:[1,1,1,1] row_mask:0xf bank_mask:0xf
    s_nop 1
    v_fmac_f32_dpp v78, v42, v3 quad_perm:[2,2,2,2] row_mask:0xf bank_mask:0xf
    s_nop 1
    v_fmac_f32_dpp v78, v43, v3 quad_perm:[3,3,3,3] row_mask:0xf bank_mask:0xf
    s_nop 1
    v_add_f32 v78, v78, v112
    s_lshl_b32 s22, s49, 9
    s_add_u32 s22, s22, 0xa0000
    s_lshl_b32 s3, s49, 6
    s_add_u32 s3, s3, 0xa2000
    s_mov_b32 exec_hi, 0
    buffer_store_dwordx4 v[96:99], v128, s[36:39], s22 offen sc1
    s_mov_b32 exec_lo, 0x1111
    buffer_store_dword v78, v110, s[36:39], s3 offen sc1
L_hdone:
    s_waitcnt vmcnt(0)
L_end:
    s_endpgm
.section .rodata,"a"
.p2align 6
.amdhsa_kernel standalone__tree_speculative_verify_tree_attention_over_candidate_token_tree__decode_kernel
  .amdhsa_next_free_vgpr 152
  .amdhsa_next_free_sgpr 96
  .amdhsa_accum_offset 152
  .amdhsa_group_segment_fixed_size 0
  .amdhsa_kernarg_size 72
  .amdhsa_user_sgpr_count 2
  .amdhsa_user_sgpr_kernarg_segment_ptr 1
  .amdhsa_system_sgpr_workgroup_id_x 1
  .amdhsa_float_denorm_mode_32 3
.end_amdhsa_kernel
```
